```python
import torch

def _softmax(x, axis=-1):
    return torch.softmax(x, dim=axis)
def _gelu(x):
    return torch.nn.functional.gelu(x, approximate="tanh")
def _silu(x):
    return torch.nn.functional.silu(x)
def _sigmoid(x):
    return torch.sigmoid(x)
def _layernorm(x, axis=-1, eps=1e-5):
    m = x.mean(dim=axis, keepdim=True)
    v = x.var(dim=axis, keepdim=True, unbiased=False)
    return (x - m) / torch.sqrt(v + eps)
def _scatter_add(tgt, idx, src, axis=0):
    return tgt.clone().index_add_(axis, idx, src)
def _segment_sum(src, seg, n):
    out = torch.zeros((n,) + src.shape[1:], dtype=src.dtype)
    return out.index_add_(0, seg, src)
def _pad(x, pw):
    flat = tuple(v for pair in reversed(pw) for v in pair)
    return torch.nn.functional.pad(x, flat)

kernel_name = 'parallel_sum__sliding_block_cached__glu_gated_glu__decode'

def setup_inputs():

    _w = (lambda a: (lambda t: t.to(torch.bfloat16) if t.is_floating_point() else t)(torch.as_tensor(a)))
    def _A_setup():
        B, Sq, D = 1, 1, 640
        Hq, Hkv, Sk, Dh = 32, 32, 8192, 128
        assert Hq % Hkv == 0, (Hq, Hkv)
        return {
            "x": _w((lambda *s: torch.randn(*s, dtype=torch.bfloat16) * 0.05)(B, Sq, D)),
            "k_cache": _w((lambda *s: torch.randn(*s, dtype=torch.bfloat16) * 3.2)(B, Hkv, Sk, Dh)),
            "v_cache": _w((lambda *s: torch.randn(*s, dtype=torch.bfloat16) * 1.6)(B, Hkv, Sk, Dh)),
            "wq": _w((lambda *s: torch.randn(*s, dtype=torch.bfloat16) * 3.2)(D, Hq * Dh) * (D ** -0.5)),
            "wo": _w((lambda *s: torch.randn(*s, dtype=torch.bfloat16) * 1.6)(Hq * Dh, D) * ((Hq * Dh) ** -0.5)),
        }
    _A_in = _A_setup()

    def _B_setup():
        B, S, D, F = 1, 1, 640, 1728
        return {
            "x": _w((lambda *s: torch.randn(*s, dtype=torch.bfloat16) * 0.05)(B, S, D)),
            "w_gate": _w((lambda *s: torch.randn(*s, dtype=torch.bfloat16) * 0.05)(D, F)),
            "w_up": _w((lambda *s: torch.randn(*s, dtype=torch.bfloat16) * 0.05)(D, F)),
            "w_down": _w((lambda *s: torch.randn(*s, dtype=torch.bfloat16) * 0.05)(F, D)),
        }
    _B_in = _B_setup()

    return {
        "A_x": _A_in["x"],
        "A_k_cache": _A_in["k_cache"],
        "A_v_cache": _A_in["v_cache"],
        "A_wq": _A_in["wq"],
        "A_wo": _A_in["wo"],
        "B_x": _B_in["x"],
        "B_w_gate": _B_in["w_gate"],
        "B_w_up": _B_in["w_up"],
        "B_w_down": _B_in["w_down"],
    }

def reference(A_x, A_k_cache, A_v_cache, A_wq, A_wo, B_x, B_w_gate, B_w_up, B_w_down):
    def _A_ref(x, k_cache, v_cache, wq, wo):
        B, Sq, D = x.shape
        Hq, Dh = 32, 128
        Hkv, Sk = k_cache.shape[1], k_cache.shape[2]
        W = min(4096, max(256, Sk // 4))
        rep = Hq // Hkv
        q = (lambda x, *d: x.permute(*d))((x @ wq).reshape(B, Sq, Hq, Dh), 0, 2, 1, 3)
        k = (lambda x, n, axis: torch.repeat_interleave(x, n, dim=axis))(k_cache[:, :, Sk - W:, :], rep, axis=1)
        v = (lambda x, n, axis: torch.repeat_interleave(x, n, dim=axis))(v_cache[:, :, Sk - W:, :], rep, axis=1)
        scores = torch.einsum("bhqd,bhkd->bhqk", q, k) * (Dh ** -0.5)
        p = _softmax(scores, axis=-1)
        o = torch.einsum("bhqk,bhkd->bhqd", p, v)
        return (lambda x, *d: x.permute(*d))(o, 0, 2, 1, 3).reshape(B, Sq, Hq * Dh) @ wo

    def _B_ref(x, w_gate, w_up, w_down):
        g = torch.einsum("bsd,df->bsf", x, w_gate)
        u = torch.einsum("bsd,df->bsf", x, w_up)
        h = _sigmoid(g) * u
        return torch.einsum("bsf,fd->bsd", h, w_down)

    x = A_x
    xn = _layernorm(x, axis=-1)
    return x + _A_ref(xn, A_k_cache, A_v_cache, A_wq, A_wo) + _B_ref(xn, B_w_gate, B_w_up, B_w_down)
```

```asm
; @launch grid=(256,1,1) block=(640,1,1) lds=13376
.amdgcn_target "amdgcn-amd-amdhsa--gfx950"
.text
.globl parallel_sum__sliding_block_cached__glu_gated_glu__decode_kernel
.p2align 8
.type parallel_sum__sliding_block_cached__glu_gated_glu__decode_kernel,@function
parallel_sum__sliding_block_cached__glu_gated_glu__decode_kernel:
    v_readfirstlane_b32 s3, v0
    s_lshr_b32 s5, s2, 5
    s_lshr_b32 s39, s3, 5
    s_and_b32 s39, s39, 28
    s_lshr_b32 s39, 0x3b1980, s39
    s_and_b32 s39, s39, 56
    s_load_dwordx2 s[18:19], s[0:1], s39
    s_cmp_ge_u32 s5, 8
    s_cbranch_scc1 L_exit
    s_lshr_b32 s3, s3, 6
    s_and_b32 s4, s2, 31
    s_sub_u32 s7, s3, 2
    s_cbranch_scc0 L_S
    s_cmp_eq_u32 s3, 0
    s_cbranch_scc0 L_H
    s_mul_i32 s6, s5, 80
    v_lshlrev_b32 v5, 4, v0
    v_lshlrev_b32 v6, 2, v0
    v_add_lshl_u32 v7, v0, s6, 1
    s_waitcnt lgkmcnt(0)
    global_load_dwordx4 v[16:19], v5, s[18:19]
    global_load_dword v20, v6, s[18:19] offset:1024
    global_load_ushort v21, v7, s[18:19]
    global_load_ushort v22, v7, s[18:19] offset:32
    s_branch L_H
L_S:
    s_movk_i32 s34, 0x2000
    s_cmp_ge_u32 s7, 4
    s_cselect_b32 s36, 3, 4
    s_cmovk_i32 s34, 0xd80
    s_cselect_b32 s59, 27, 32
    v_bfe_u32 v14, v0, s36, 4
    v_bfe_u32 v6, v0, 0, s36
    s_mul_i32 s35, s34, 5
    v_lshl_add_u32 v4, s5, 4, v14
    s_lshl_b32 s37, s4, s36
    v_mul_u32_u24 v4, s35, v4
    v_add_u32 v6, s37, v6
    v_lshl_add_u32 v4, v6, 4, v4
    s_cmp_ge_u32 s4, s59
    s_cbranch_scc1 L_now0
    s_waitcnt lgkmcnt(0)
    global_load_dwordx4 v[48:51], v4, s[18:19] nt
    v_add_u32 v4, s34, v4
    global_load_dwordx4 v[52:55], v4, s[18:19] nt
    v_add_u32 v4, s34, v4
    global_load_dwordx4 v[56:59], v4, s[18:19] nt
L_now0:
    s_load_dwordx8 s[8:15], s[0:1], 0
    s_load_dwordx2 s[16:17], s[0:1], 32
    s_load_dwordx8 s[24:31], s[0:1], 64
    v_and_b32 v1, 63, v0
    s_mov_b32 s32, s4
    s_xor_b32 s37, s7, s5
    s_xor_b32 s37, s37, s4
    s_and_b32 s37, s37, 7
    s_and_b32 s38, s37, 3
    s_lshl2_add_u32 s37, s37, s38
    s_lshl2_add_u32 s36, s4, 3
    s_lshl3_add_u32 s36, s36, s5
    s_lshl3_add_u32 s36, s36, s7
    s_lshl_b32 s36, s36, 5
    s_or_b32 s36, s36, s37
    s_lshl_b32 s36, s36, 8
    v_and_b32 v3, 15, v0
    v_and_b32 v5, 12, v0
    v_lshrrev_b32 v2, 4, v1
    v_and_b32 v6, 3, v0
    v_lshl_add_u32 v47, v2, 2, v6
    v_lshlrev_b32 v47, 4, v47
    v_lshl_add_u32 v5, v5, 6, v47
    v_xor_b32 v5, s36, v5
    v_lshlrev_b32 v6, 10, v2
    v_lshl_add_u32 v6, v3, 4, v6
    v_xor_b32 v6, s36, v6
    v_and_b32 v12, 1, v3
    v_lshlrev_b32 v12, 4, v12
    v_mov_b32 v13, 0xffff
    v_lshlrev_b32 v12, v12, v13
    v_bfe_u32 v13, v3, 1, 2
    v_cmp_eq_u32 s[40:41], 0, v13
    v_cmp_eq_u32 s[42:43], 1, v13
    v_cmp_eq_u32 s[44:45], 2, v13
    v_cmp_eq_u32 s[46:47], 3, v13
    v_cndmask_b32 v8, 0, v12, s[40:41]
    v_cndmask_b32 v9, 0, v12, s[42:43]
    v_cndmask_b32 v10, 0, v12, s[44:45]
    v_cndmask_b32 v11, 0, v12, s[46:47]
    s_cmp_ge_u32 s7, 4
    s_cselect_b32 s36, 9, 8
    s_lshl_b32 s37, s7, 9
    s_and_b32 s38, s7, 1
    s_lshl_b32 s38, s38, 10
    s_and_b32 s39, s7, 2
    s_lshl_b32 s39, s39, 7
    s_add_u32 s38, s38, s39
    s_add_u32 s38, s38, 0x800
    s_cmp_ge_u32 s7, 4
    s_cselect_b32 s37, s38, s37
    v_lshrrev_b32 v12, 3, v3
    v_lshlrev_b32 v12, s36, v12
    v_and_b32 v13, 7, v3
    v_lshl_add_u32 v12, v13, 5, v12
    v_and_b32 v13, 1, v2
    v_lshl_add_u32 v12, v13, 4, v12
    v_add_u32 v13, s37, v12
    v_lshlrev_b32 v14, 5, v14
    s_mov_b32 s54, 0x00ff00ff
    s_mov_b32 s55, 0xff00ff00
    s_cmp_ge_u32 s4, s59
    s_cbranch_scc1 L_now1
    v_add_u32 v4, s34, v4
    s_waitcnt vmcnt(2)
    global_load_dwordx4 v[60:63], v4, s[18:19] nt
    v_add_u32 v4, s34, v4
    s_waitcnt vmcnt(2)
    global_load_dwordx4 v[64:67], v4, s[18:19] nt
L_now1:
    s_waitcnt lgkmcnt(0)
    s_load_dword s33, s[30:31], 0
    s_waitcnt vmcnt(2)
    global_load_dwordx4 v[68:71], v5, s[10:11] nt
    s_barrier
    ds_read_b128 v[40:43], v14 offset:0
    ds_read_b32 v44, v14 offset:16
    s_waitcnt lgkmcnt(0)
    v_and_b32 v16, v40, v8
    v_and_b32 v17, v40, v9
    v_and_b32 v18, v40, v10
    v_and_b32 v19, v40, v11
    v_and_b32 v20, v41, v8
    v_and_b32 v21, v41, v9
    v_and_b32 v22, v41, v10
    v_and_b32 v23, v41, v11
    v_and_b32 v24, v42, v8
    v_and_b32 v25, v42, v9
    v_and_b32 v26, v42, v10
    v_and_b32 v27, v42, v11
    v_and_b32 v28, v43, v8
    v_and_b32 v29, v43, v9
    v_and_b32 v30, v43, v10
    v_and_b32 v31, v43, v11
    v_and_b32 v32, v44, v8
    v_and_b32 v33, v44, v9
    v_and_b32 v34, v44, v10
    v_and_b32 v35, v44, v11
    v_xor_b32 v5, 1024, v5
    s_waitcnt vmcnt(2)
    global_load_dwordx4 v[72:75], v5, s[10:11] nt
    v_xor_b32 v5, 3072, v5
    s_waitcnt vmcnt(2)
    global_load_dwordx4 v[76:79], v5, s[10:11] nt
    v_xor_b32 v5, 1024, v5
    s_waitcnt vmcnt(2)
    global_load_dwordx4 v[80:83], v5, s[10:11] nt
    s_waitcnt vmcnt(4)
    v_mfma_f32_16x16x32_bf16 v[40:43], v[16:19], v[48:51], 0
    v_mfma_f32_16x16x32_bf16 v[40:43], v[20:23], v[52:55], v[40:43]
    v_mfma_f32_16x16x32_bf16 v[40:43], v[24:27], v[56:59], v[40:43]
    v_mfma_f32_16x16x32_bf16 v[40:43], v[28:31], v[60:63], v[40:43]
    v_mfma_f32_16x16x32_bf16 v[40:43], v[32:35], v[64:67], v[40:43]
    s_mul_i32 s33, s33, 1664525
    s_add_u32 s33, s33, 1013904223
    s_mov_b64 exec, s[54:55]
    s_mov_b32 s40, 983055
    s_mov_b32 s41, s40
    s_mov_b32 s42, 15728880
    s_mov_b32 s43, s42
    s_mov_b32 s44, 251662080
    s_mov_b32 s45, s44
    s_mov_b32 s46, 4026593280
    s_mov_b32 s47, s46
    ds_write_b128 v13, v[40:43] offset:1088
    s_mov_b64 exec, -1
    s_waitcnt lgkmcnt(0)
    s_barrier
    s_mov_b32 s48, 572662306
    s_mov_b32 s49, s48
    s_mov_b32 s50, 1145324612
    s_mov_b32 s51, s50
    s_mov_b32 s52, 2290649224
    s_mov_b32 s53, s52
    s_lshl3_add_u32 s36, s4, s7
    s_and_b32 s37, s7, 3
    s_lshl2_add_u32 s37, s4, s37
    s_lshr_b32 s38, s7, 2
    s_lshl1_add_u32 s38, s5, s38
    s_sub_u32 s38, s38, 10
    s_cmp_ge_u32 s4, 27
    s_cselect_b32 s38, 5, s38
    s_cmp_lt_u32 s5, 5
    s_cselect_b64 s[18:19], s[16:17], s[24:25]
    s_cselect_b32 s36, s36, s37
    s_cselect_b32 s38, s5, s38
    s_mul_i32 s36, s36, 20480
    s_lshl_b32 s37, s38, 8
    s_add_u32 s36, s36, s37
    v_mul_u32_u24 v7, 5120, v2
    v_lshl_add_u32 v7, v3, 4, v7
    v_add_u32 v7, s36, v7
    s_cmp_lt_u32 s38, 5
    s_cselect_b32 s36, -1, 0
    v_and_b32 v7, s36, v7
    s_lshl_b32 s36, s7, 9
    v_lshlrev_b32 v4, 5, v3
    v_lshl_add_u32 v4, v2, 4, v4
    v_add_u32 v4, s36, v4
    s_lshl_b32 s36, s7, 3
    v_mov_b32 v12, s36
    s_and_b32 s36, s7, 3
    s_lshl_b32 s36, s36, 6
    v_lshl_add_u32 v14, v2, 4, s36
    s_lshl_b32 s36, s4, 13
    s_lshl_b32 s37, s7, 7
    s_add_u32 s36, s36, s37
    s_add_u32 s36, s36, 589824
    v_lshrrev_b32 v13, 1, v3
    v_lshlrev_b32 v13, 10, v13
    v_lshl_add_u32 v13, v2, 5, v13
    v_and_b32 v45, 1, v3
    v_lshl_add_u32 v13, v45, 4, v13
    v_add_u32 v13, s36, v13
    v_xor_b32 v5, 7168, v5
    s_waitcnt vmcnt(2)
    global_load_dwordx4 v[84:87], v5, s[10:11] nt
    v_xor_b32 v5, 1024, v5
    s_waitcnt vmcnt(2)
    global_load_dwordx4 v[88:91], v5, s[10:11] nt
    v_xor_b32 v5, 3072, v5
    s_waitcnt vmcnt(2)
    global_load_dwordx4 v[92:95], v5, s[10:11] nt
    v_xor_b32 v5, 1024, v5
    s_waitcnt vmcnt(2)
    global_load_dwordx4 v[96:99], v5, s[10:11] nt
    s_waitcnt vmcnt(2)
    global_load_dwordx4 v[100:103], v6, s[12:13] nt
    v_xor_b32 v6, 256, v6
    s_waitcnt vmcnt(2)
    global_load_dwordx4 v[104:107], v6, s[12:13] nt
    v_xor_b32 v6, 768, v6
    s_waitcnt vmcnt(2)
    global_load_dwordx4 v[108:111], v6, s[12:13] nt
    v_xor_b32 v6, 256, v6
    s_waitcnt vmcnt(2)
    global_load_dwordx4 v[112:115], v6, s[12:13] nt
    v_xor_b32 v6, 4864, v6
    s_waitcnt vmcnt(2)
    global_load_dwordx4 v[116:119], v6, s[12:13] nt
    s_barrier
    ds_read_b128 v[32:35], v47 offset:576
    s_waitcnt lgkmcnt(0)
    v_cndmask_b32 v16, 0, v32, s[40:41]
    v_cndmask_b32 v17, 0, v33, s[40:41]
    v_cndmask_b32 v18, 0, v34, s[40:41]
    v_cndmask_b32 v19, 0, v35, s[40:41]
    v_cndmask_b32 v20, 0, v32, s[42:43]
    v_cndmask_b32 v21, 0, v33, s[42:43]
    v_cndmask_b32 v22, 0, v34, s[42:43]
    v_cndmask_b32 v23, 0, v35, s[42:43]
    v_cndmask_b32 v24, 0, v32, s[44:45]
    v_cndmask_b32 v25, 0, v33, s[44:45]
    v_cndmask_b32 v26, 0, v34, s[44:45]
    v_cndmask_b32 v27, 0, v35, s[44:45]
    v_cndmask_b32 v28, 0, v32, s[46:47]
    v_cndmask_b32 v29, 0, v33, s[46:47]
    v_cndmask_b32 v30, 0, v34, s[46:47]
    v_cndmask_b32 v31, 0, v35, s[46:47]
    s_waitcnt vmcnt(5)
    v_mfma_f32_16x16x32_bf16 v[36:39], v[16:19], v[68:71], 0
    v_mfma_f32_16x16x32_bf16 v[40:43], v[16:19], v[84:87], 0
    v_mfma_f32_16x16x32_bf16 v[36:39], v[20:23], v[72:75], v[36:39]
    v_mfma_f32_16x16x32_bf16 v[40:43], v[20:23], v[88:91], v[40:43]
    v_mfma_f32_16x16x32_bf16 v[36:39], v[24:27], v[76:79], v[36:39]
    v_mfma_f32_16x16x32_bf16 v[40:43], v[24:27], v[92:95], v[40:43]
    v_mfma_f32_16x16x32_bf16 v[36:39], v[28:31], v[80:83], v[36:39]
    v_mfma_f32_16x16x32_bf16 v[40:43], v[28:31], v[96:99], v[40:43]
    s_nop 6
    v_cndmask_b32 v36, v36, v37, s[48:49]
    v_cndmask_b32 v40, v40, v41, s[48:49]
    v_cndmask_b32 v36, v36, v38, s[50:51]
    v_cndmask_b32 v40, v40, v42, s[50:51]
    v_cndmask_b32 v36, v36, v39, s[52:53]
    v_cndmask_b32 v40, v40, v43, s[52:53]
    s_nop 0
    v_add_f32_dpp v36, v36, v36 quad_perm:[1,0,3,2] row_mask:0xf bank_mask:0xf
    v_add_f32_dpp v40, v40, v40 quad_perm:[1,0,3,2] row_mask:0xf bank_mask:0xf
    s_nop 0
    v_add_f32_dpp v36, v36, v36 quad_perm:[2,3,0,1] row_mask:0xf bank_mask:0xf
    v_add_f32_dpp v40, v40, v40 quad_perm:[2,3,0,1] row_mask:0xf bank_mask:0xf
    v_cvt_pk_bf16_f32 v37, v36, v40
    v_lshlrev_b32 v36, 16, v37
    v_and_b32 v40, 0xffff0000, v37
    v_mul_f32 v36, 0x3db504f3, v36
    v_mul_f32 v40, 0x3db504f3, v40
    v_cvt_pk_bf16_f32 v37, v36, v40
    v_lshlrev_b32 v36, 16, v37
    v_and_b32 v40, 0xffff0000, v37
    v_max_f32 v44, v36, v40
    s_nop 1
    v_max_f32_dpp v44, v44, v44 row_ror:4 row_mask:0xf bank_mask:0xf
    s_nop 1
    v_max_f32_dpp v44, v44, v44 row_ror:8 row_mask:0xf bank_mask:0xf
    v_mov_b32 v37, v44
    s_nop 1
    v_permlane16_swap_b32 v44, v37
    v_max_f32 v44, v44, v37
    v_mov_b32 v37, v44
    s_nop 1
    v_permlane32_swap_b32 v44, v37
    v_max_f32 v44, v44, v37
    v_sub_f32 v36, v36, v44
    v_sub_f32 v40, v40, v44
    v_mul_f32 v36, 0x3fb8aa3b, v36
    v_mul_f32 v40, 0x3fb8aa3b, v40
    v_exp_f32 v36, v36
    v_exp_f32 v40, v40
    s_nop 0
    v_add_f32 v45, v36, v40
    v_cvt_pk_bf16_f32 v38, v36, v36
    v_cvt_pk_bf16_f32 v39, v40, v40
    v_add_f32_dpp v45, v45, v45 row_ror:4 row_mask:0xf bank_mask:0xf
    s_nop 1
    v_add_f32_dpp v45, v45, v45 row_ror:8 row_mask:0xf bank_mask:0xf
    v_mov_b32 v37, v45
    s_nop 1
    v_permlane16_swap_b32 v45, v37
    v_add_f32 v45, v45, v37
    v_mov_b32 v37, v45
    s_nop 1
    v_permlane32_swap_b32 v45, v37
    v_add_f32 v45, v45, v37
    ds_write_b64 v12, v[44:45] offset:512
    v_and_b32_dpp v68, v38, v8 row_newbcast:0 row_mask:0xf bank_mask:0xf
    v_and_b32_dpp v69, v38, v9 row_newbcast:0 row_mask:0xf bank_mask:0xf
    v_and_b32_dpp v70, v38, v10 row_newbcast:0 row_mask:0xf bank_mask:0xf
    v_and_b32_dpp v71, v38, v11 row_newbcast:0 row_mask:0xf bank_mask:0xf
    v_and_b32_dpp v72, v38, v8 row_newbcast:4 row_mask:0xf bank_mask:0xf
    v_and_b32_dpp v73, v38, v9 row_newbcast:4 row_mask:0xf bank_mask:0xf
    v_and_b32_dpp v74, v38, v10 row_newbcast:4 row_mask:0xf bank_mask:0xf
    v_and_b32_dpp v75, v38, v11 row_newbcast:4 row_mask:0xf bank_mask:0xf
    v_and_b32_dpp v76, v38, v8 row_newbcast:8 row_mask:0xf bank_mask:0xf
    v_and_b32_dpp v77, v38, v9 row_newbcast:8 row_mask:0xf bank_mask:0xf
    v_and_b32_dpp v78, v38, v10 row_newbcast:8 row_mask:0xf bank_mask:0xf
    v_and_b32_dpp v79, v38, v11 row_newbcast:8 row_mask:0xf bank_mask:0xf
    v_and_b32_dpp v80, v38, v8 row_newbcast:12 row_mask:0xf bank_mask:0xf
    v_and_b32_dpp v81, v38, v9 row_newbcast:12 row_mask:0xf bank_mask:0xf
    v_and_b32_dpp v82, v38, v10 row_newbcast:12 row_mask:0xf bank_mask:0xf
    v_and_b32_dpp v83, v38, v11 row_newbcast:12 row_mask:0xf bank_mask:0xf
    v_xor_b32 v6, 256, v6
    s_waitcnt vmcnt(2)
    global_load_dwordx4 v[120:123], v6, s[12:13] nt
    v_xor_b32 v6, 768, v6
    s_waitcnt vmcnt(2)
    global_load_dwordx4 v[124:127], v6, s[12:13] nt
    v_xor_b32 v6, 256, v6
    s_waitcnt vmcnt(2)
    global_load_dwordx4 v[128:131], v6, s[12:13] nt
    s_waitcnt lgkmcnt(0)
    s_barrier
    v_and_b32_dpp v84, v39, v8 row_newbcast:0 row_mask:0xf bank_mask:0xf
    v_and_b32_dpp v85, v39, v9 row_newbcast:0 row_mask:0xf bank_mask:0xf
    v_and_b32_dpp v86, v39, v10 row_newbcast:0 row_mask:0xf bank_mask:0xf
    v_and_b32_dpp v87, v39, v11 row_newbcast:0 row_mask:0xf bank_mask:0xf
    v_and_b32_dpp v88, v39, v8 row_newbcast:4 row_mask:0xf bank_mask:0xf
    v_and_b32_dpp v89, v39, v9 row_newbcast:4 row_mask:0xf bank_mask:0xf
    v_and_b32_dpp v90, v39, v10 row_newbcast:4 row_mask:0xf bank_mask:0xf
    v_and_b32_dpp v91, v39, v11 row_newbcast:4 row_mask:0xf bank_mask:0xf
    v_and_b32_dpp v92, v39, v8 row_newbcast:8 row_mask:0xf bank_mask:0xf
    v_and_b32_dpp v93, v39, v9 row_newbcast:8 row_mask:0xf bank_mask:0xf
    v_and_b32_dpp v94, v39, v10 row_newbcast:8 row_mask:0xf bank_mask:0xf
    v_and_b32_dpp v95, v39, v11 row_newbcast:8 row_mask:0xf bank_mask:0xf
    v_and_b32_dpp v96, v39, v8 row_newbcast:12 row_mask:0xf bank_mask:0xf
    v_and_b32_dpp v97, v39, v9 row_newbcast:12 row_mask:0xf bank_mask:0xf
    v_and_b32_dpp v98, v39, v10 row_newbcast:12 row_mask:0xf bank_mask:0xf
    v_and_b32_dpp v99, v39, v11 row_newbcast:12 row_mask:0xf bank_mask:0xf
    v_mov_b32 v47, s33
    s_mov_b32 s39, 262144
    s_waitcnt vmcnt(7)
    v_mfma_f32_16x16x32_bf16 v[40:43], v[68:71], v[100:103], 0
    s_waitcnt vmcnt(6)
    v_mfma_f32_16x16x32_bf16 v[40:43], v[72:75], v[104:107], v[40:43]
    s_waitcnt vmcnt(5)
    v_mfma_f32_16x16x32_bf16 v[40:43], v[76:79], v[108:111], v[40:43]
    s_waitcnt vmcnt(4)
    v_mfma_f32_16x16x32_bf16 v[40:43], v[80:83], v[112:115], v[40:43]
    s_waitcnt vmcnt(3)
    v_mfma_f32_16x16x32_bf16 v[40:43], v[84:87], v[116:119], v[40:43]
    s_waitcnt vmcnt(2)
    global_load_dwordx4 v[132:135], v7, s[18:19] offset:0 nt
    s_waitcnt vmcnt(3)
    v_mfma_f32_16x16x32_bf16 v[40:43], v[88:91], v[120:123], v[40:43]
    s_waitcnt vmcnt(2)
    global_load_dwordx4 v[136:139], v7, s[18:19] offset:1280 nt
    s_waitcnt vmcnt(3)
    v_mfma_f32_16x16x32_bf16 v[40:43], v[92:95], v[124:127], v[40:43]
    s_waitcnt vmcnt(2)
    v_mfma_f32_16x16x32_bf16 v[40:43], v[96:99], v[128:131], v[40:43]
    s_mov_b32 exec_hi, 0
    s_nop 6
    ds_write_b128 v4, v[40:43] offset:5184
    s_mov_b32 exec_hi, -1
    s_waitcnt lgkmcnt(0)
    s_barrier
    s_barrier
    global_load_dwordx4 v[140:143], v7, s[18:19] offset:2560 nt
    global_load_dwordx4 v[144:147], v7, s[18:19] offset:3840 nt
    s_cmp_lt_u32 s5, 5
    s_cbranch_scc1 L_attn
    ds_read_b128 v[48:51], v14 offset:832
    s_waitcnt lgkmcnt(0)
    v_and_b32 v16, v48, v8
    v_and_b32 v17, v48, v9
    v_and_b32 v18, v48, v10
    v_and_b32 v19, v48, v11
    v_and_b32 v20, v49, v8
    v_and_b32 v21, v49, v9
    v_and_b32 v22, v49, v10
    v_and_b32 v23, v49, v11
    v_and_b32 v24, v50, v8
    v_and_b32 v25, v50, v9
    v_and_b32 v26, v50, v10
    v_and_b32 v27, v50, v11
    v_and_b32 v28, v51, v8
    v_and_b32 v29, v51, v9
    v_and_b32 v30, v51, v10
    v_and_b32 v31, v51, v11
    s_waitcnt vmcnt(3)
    v_mfma_f32_16x16x32_bf16 v[36:39], v[16:19], v[132:135], 0
    s_waitcnt vmcnt(2)
    v_mfma_f32_16x16x32_bf16 v[36:39], v[20:23], v[136:139], v[36:39]
    s_waitcnt vmcnt(1)
    v_mfma_f32_16x16x32_bf16 v[36:39], v[24:27], v[140:143], v[36:39]
    s_waitcnt vmcnt(0)
    s_branch L_lastmf
L_retry2:
    s_sub_u32 s39, s39, 1
    s_cbranch_scc1 L_got2
L_attn:
    s_waitcnt vmcnt(3)
L_poll2:
    global_load_dwordx4 v[32:35], v13, s[30:31] sc1
    s_waitcnt vmcnt(0)
    v_max_f32_dpp v12, v34, v34 quad_perm:[2,3,0,1] row_mask:0xf bank_mask:0xf
    v_cmp_ne_u32 vcc, v35, v47
    s_nop 0
    v_max_f32_dpp v12, v12, v12 row_ror:4 row_mask:0xf bank_mask:0xf
    s_cbranch_vccnz L_retry2
L_got2:
    s_nop 0
    v_max_f32_dpp v12, v12, v12 row_ror:8 row_mask:0xf bank_mask:0xf
    v_sub_f32 v34, v34, v12
    v_exp_f32 v34, v34
    s_nop 0
    v_mul_f32 v32, v32, v34
    v_mul_f32 v33, v33, v34
    v_add_f32_dpp v34, v34, v34 quad_perm:[2,3,0,1] row_mask:0xf bank_mask:0xf
    v_add_f32_dpp v32, v32, v32 quad_perm:[2,3,0,1] row_mask:0xf bank_mask:0xf
    v_add_f32_dpp v33, v33, v33 quad_perm:[2,3,0,1] row_mask:0xf bank_mask:0xf
    v_add_f32_dpp v34, v34, v34 row_ror:4 row_mask:0xf bank_mask:0xf
    v_add_f32_dpp v32, v32, v32 row_ror:4 row_mask:0xf bank_mask:0xf
    v_add_f32_dpp v33, v33, v33 row_ror:4 row_mask:0xf bank_mask:0xf
    v_add_f32_dpp v34, v34, v34 row_ror:8 row_mask:0xf bank_mask:0xf
    v_rcp_f32 v34, v34
    v_add_f32_dpp v32, v32, v32 row_ror:8 row_mask:0xf bank_mask:0xf
    v_add_f32_dpp v33, v33, v33 row_ror:8 row_mask:0xf bank_mask:0xf
    v_mul_f32 v32, v32, v34
    v_mul_f32 v33, v33, v34
    v_cvt_pk_bf16_f32 v32, v32, v32
    v_cvt_pk_bf16_f32 v33, v33, v33
    s_nop 0
    v_and_b32_dpp v16, v32, v8 row_newbcast:0 row_mask:0xf bank_mask:0xf
    v_and_b32_dpp v17, v32, v9 row_newbcast:0 row_mask:0xf bank_mask:0xf
    v_and_b32_dpp v18, v32, v10 row_newbcast:0 row_mask:0xf bank_mask:0xf
    v_and_b32_dpp v19, v32, v11 row_newbcast:0 row_mask:0xf bank_mask:0xf
    v_and_b32_dpp v20, v33, v8 row_newbcast:0 row_mask:0xf bank_mask:0xf
    v_and_b32_dpp v21, v33, v9 row_newbcast:0 row_mask:0xf bank_mask:0xf
    v_and_b32_dpp v22, v33, v10 row_newbcast:0 row_mask:0xf bank_mask:0xf
    v_and_b32_dpp v23, v33, v11 row_newbcast:0 row_mask:0xf bank_mask:0xf
    v_mfma_f32_16x16x32_bf16 v[36:39], v[16:19], v[132:135], 0
    v_and_b32_dpp v24, v32, v8 row_newbcast:1 row_mask:0xf bank_mask:0xf
    v_and_b32_dpp v25, v32, v9 row_newbcast:1 row_mask:0xf bank_mask:0xf
    v_and_b32_dpp v26, v32, v10 row_newbcast:1 row_mask:0xf bank_mask:0xf
    v_and_b32_dpp v27, v32, v11 row_newbcast:1 row_mask:0xf bank_mask:0xf
    v_mfma_f32_16x16x32_bf16 v[36:39], v[20:23], v[136:139], v[36:39]
    v_and_b32_dpp v28, v33, v8 row_newbcast:1 row_mask:0xf bank_mask:0xf
    v_and_b32_dpp v29, v33, v9 row_newbcast:1 row_mask:0xf bank_mask:0xf
    v_and_b32_dpp v30, v33, v10 row_newbcast:1 row_mask:0xf bank_mask:0xf
    v_and_b32_dpp v31, v33, v11 row_newbcast:1 row_mask:0xf bank_mask:0xf
    v_mfma_f32_16x16x32_bf16 v[36:39], v[24:27], v[140:143], v[36:39]
    s_nop 0
L_lastmf:
    v_mfma_f32_16x16x32_bf16 v[36:39], v[28:31], v[144:147], v[36:39]
    s_mov_b32 exec_hi, 0
    s_nop 6
    ds_write_b128 v4, v[36:39] offset:9280
    s_waitcnt lgkmcnt(0)
    s_barrier
    s_endpgm
L_H:
    v_and_b32 v1, 63, v0
    v_lshlrev_b32 v5, 4, v1
    v_lshlrev_b32 v6, 2, v1
    s_load_dwordx8 s[8:15], s[0:1], 0
    s_load_dwordx2 s[16:17], s[0:1], 32
    s_load_dwordx8 s[24:31], s[0:1], 64
    s_waitcnt lgkmcnt(0)
    s_load_dword s33, s[30:31], 0
    s_mov_b32 s32, s4
    s_lshl_b32 s36, s4, 13
    s_lshl_b32 s37, s5, 10
    s_add_u32 s36, s36, s37
    s_add_u32 s36, s36, 589824
    v_add_u32 v8, s36, v5
    s_lshl_b32 s36, s5, 1
    s_sub_u32 s36, s36, 5
    s_cmp_lt_u32 s5, 5
    s_cselect_b32 s36, s5, s36
    s_lshl_b32 s36, s36, 15
    s_lshl_b32 s37, s4, 7
    s_add_u32 s36, s36, s37
    s_add_u32 s36, s36, 851968
    v_lshrrev_b32 v9, 3, v1
    v_lshlrev_b32 v9, 12, v9
    v_and_b32 v12, 7, v1
    v_lshl_add_u32 v9, v12, 4, v9
    v_add_u32 v9, s36, v9
    v_add_u32 v10, 32768, v9
    s_sub_u32 s50, s2, 216
    s_min_u32 s36, s50, 39
    s_lshl_b32 s36, s36, 5
    v_lshl_add_u32 v11, v12, 2, s36
    s_cmp_eq_u32 s3, 0
    s_cbranch_scc0 L_H1
    v_mul_u32_u24 v12, 205, v1
    v_lshrrev_b32 v12, 10, v12
    v_mad_u32_u24 v12, v12, 12, v6
    v_add_u32 v13, 16, v1
    v_mul_u32_u24 v14, 205, v13
    v_lshrrev_b32 v14, 10, v14
    v_lshlrev_b32 v13, 2, v13
    v_mad_u32_u24 v13, v14, 12, v13
    s_waitcnt vmcnt(2)
    v_lshlrev_b32 v24, 16, v16
    v_and_b32 v25, 0xffff0000, v16
    v_lshlrev_b32 v26, 16, v17
    v_and_b32 v27, 0xffff0000, v17
    v_lshlrev_b32 v28, 16, v18
    v_and_b32 v29, 0xffff0000, v18
    v_lshlrev_b32 v30, 16, v19
    v_and_b32 v31, 0xffff0000, v19
    v_lshlrev_b32 v32, 16, v20
    v_and_b32 v33, 0xffff0000, v20
    v_add_f32 v34, v24, v25
    v_add_f32 v34, v34, v26
    v_add_f32 v34, v34, v27
    v_add_f32 v34, v34, v28
    v_add_f32 v34, v34, v29
    v_add_f32 v34, v34, v30
    v_add_f32 v34, v34, v31
    v_add_f32 v34, v34, v32
    v_add_f32 v34, v34, v33
    s_nop 1
    v_add_f32_dpp v34, v34, v34 quad_perm:[1,0,3,2] row_mask:0xf bank_mask:0xf
    s_nop 1
    v_add_f32_dpp v34, v34, v34 quad_perm:[2,3,0,1] row_mask:0xf bank_mask:0xf
    s_nop 1
    v_add_f32_dpp v34, v34, v34 row_ror:4 row_mask:0xf bank_mask:0xf
    s_nop 1
    v_add_f32_dpp v34, v34, v34 row_ror:8 row_mask:0xf bank_mask:0xf
    v_mov_b32 v35, v34
    s_nop 1
    v_permlane16_swap_b32 v34, v35
    v_add_f32 v34, v34, v35
    v_mov_b32 v35, v34
    s_nop 1
    v_permlane32_swap_b32 v34, v35
    v_add_f32 v34, v34, v35
    v_mul_f32 v34, 0x3acccccd, v34
    v_sub_f32 v24, v24, v34
    v_sub_f32 v25, v25, v34
    v_sub_f32 v26, v26, v34
    v_sub_f32 v27, v27, v34
    v_sub_f32 v28, v28, v34
    v_sub_f32 v29, v29, v34
    v_sub_f32 v30, v30, v34
    v_sub_f32 v31, v31, v34
    v_sub_f32 v32, v32, v34
    v_sub_f32 v33, v33, v34
    v_mul_f32 v36, v24, v24
    v_fmac_f32 v36, v25, v25
    v_fmac_f32 v36, v26, v26
    v_fmac_f32 v36, v27, v27
    v_fmac_f32 v36, v28, v28
    v_fmac_f32 v36, v29, v29
    v_fmac_f32 v36, v30, v30
    v_fmac_f32 v36, v31, v31
    v_fmac_f32 v36, v32, v32
    v_fmac_f32 v36, v33, v33
    s_nop 1
    v_add_f32_dpp v36, v36, v36 quad_perm:[1,0,3,2] row_mask:0xf bank_mask:0xf
    s_nop 1
    v_add_f32_dpp v36, v36, v36 quad_perm:[2,3,0,1] row_mask:0xf bank_mask:0xf
    s_nop 1
    v_add_f32_dpp v36, v36, v36 row_ror:4 row_mask:0xf bank_mask:0xf
    s_nop 1
    v_add_f32_dpp v36, v36, v36 row_ror:8 row_mask:0xf bank_mask:0xf
    v_mov_b32 v35, v36
    s_nop 1
    v_permlane16_swap_b32 v36, v35
    v_add_f32 v36, v36, v35
    v_mov_b32 v35, v36
    s_nop 1
    v_permlane32_swap_b32 v36, v35
    v_add_f32 v36, v36, v35
    v_mul_f32 v36, 0x3acccccd, v36
    v_cvt_pk_bf16_f32 v34, v34, v34
    v_and_b32 v34, 0xffff0000, v34
    v_cvt_pk_bf16_f32 v36, v36, v36
    v_and_b32 v36, 0xffff0000, v36
    v_add_f32 v36, 0x3727c5ac, v36
    v_cvt_pk_bf16_f32 v36, v36, v36
    v_and_b32 v36, 0xffff0000, v36
    v_sqrt_f32 v36, v36
    s_nop 0
    v_cvt_pk_bf16_f32 v36, v36, v36
    v_and_b32 v36, 0xffff0000, v36
    v_rcp_f32 v36, v36
    s_waitcnt vmcnt(0)
    v_lshlrev_b32 v21, 16, v21
    v_lshlrev_b32 v22, 16, v22
    v_sub_f32 v21, v21, v34
    v_sub_f32 v22, v22, v34
    v_cvt_pk_bf16_f32 v21, v21, v21
    v_and_b32 v21, 0xffff0000, v21
    v_cvt_pk_bf16_f32 v22, v22, v22
    v_and_b32 v22, 0xffff0000, v22
    v_mul_f32 v21, v21, v36
    v_mul_f32 v22, v22, v36
    v_cvt_pk_bf16_f32 v21, v21, v21
    v_cvt_pk_bf16_f32 v22, v22, v22
    ds_write_b32 v12, v21 offset:0
    ds_write_b32 v13, v22 offset:0
    s_branch L_Hx
L_H1:
    s_waitcnt vmcnt(0)
    global_load_dword v40, v11, s[8:9]
L_Hx:
    s_waitcnt lgkmcnt(0)
    s_mul_i32 s33, s33, 1664525
    s_add_u32 s33, s33, 1013904223
    s_barrier
    s_mul_i32 s36, s3, 262144
    s_lshl_b32 s37, s4, 13
    s_add_u32 s36, s36, s37
    s_add_u32 s36, s36, 65536
    s_lshl_b32 s37, s5, 10
    s_add_u32 s37, s37, s36
    s_add_u32 s36, s36, 0x1000
    v_add_u32 v6, s37, v5
    v_add_u32 v7, s36, v5
    v_mov_b32 v47, s33
    v_lshlrev_b32 v14, 3, v1
    v_add_u32 v15, 262144, v6
    s_getreg_b32 s56, hwreg(HW_REG_XCC_ID, 0, 4)
    v_mov_b32 v35, s33
    v_mov_b32 v46, s56
    s_mov_b32 s39, 262144
    s_mov_b32 s57, 3
    s_cmp_eq_u32 s3, 0
    s_cbranch_scc0 L_H1b
    s_barrier
    ds_read_b64 v[16:17], v14 offset:1088
    ds_read_b64 v[18:19], v14 offset:1600
    ds_read_b64 v[20:21], v14 offset:2112
    ds_read_b64 v[22:23], v14 offset:2624
    ds_read_b64 v[24:25], v14 offset:3136
    ds_read_b64 v[26:27], v14 offset:3648
    ds_read_b64 v[28:29], v14 offset:4160
    ds_read_b64 v[30:31], v14 offset:4672
    s_waitcnt lgkmcnt(4)
    v_add_f32 v16, v16, v18
    v_add_f32 v17, v17, v19
    v_add_f32 v20, v20, v22
    v_add_f32 v21, v21, v23
    v_add_f32 v44, v16, v20
    v_add_f32 v45, v17, v21
    global_store_dwordx4 v6, v[44:47], s[30:31]
    s_waitcnt lgkmcnt(0)
    v_add_f32 v24, v24, v26
    v_add_f32 v25, v25, v27
    v_add_f32 v28, v28, v30
    v_add_f32 v29, v29, v31
    v_add_f32 v32, v24, v28
    v_add_f32 v33, v25, v29
    s_cmp_ge_u32 s4, 27
    s_cbranch_scc1 L_nogu
    global_store_dwordx4 v15, v[32:35], s[30:31]
L_nogu:
    s_waitcnt vmcnt(0)
L_poll1:
    global_load_dwordx4 v[48:51], v7, s[30:31] offset:-4096 sc1
    global_load_dwordx4 v[52:55], v7, s[30:31] offset:-3072 sc1
    global_load_dwordx4 v[56:59], v7, s[30:31] offset:-2048 sc1
    global_load_dwordx4 v[60:63], v7, s[30:31] offset:-1024 sc1
    global_load_dwordx4 v[64:67], v7, s[30:31] offset:0 sc1
    global_load_dwordx4 v[68:71], v7, s[30:31] offset:1024 sc1
    global_load_dwordx4 v[72:75], v7, s[30:31] offset:2048 sc1
    global_load_dwordx4 v[76:79], v7, s[30:31] offset:3072 sc1
    s_sub_u32 s39, s39, 1
    s_cbranch_scc1 L_got1
    s_waitcnt vmcnt(0)
    v_min3_u32 v13, v51, v55, v59
    v_max3_u32 v12, v51, v55, v59
    v_min3_u32 v13, v13, v63, v67
    v_max3_u32 v12, v12, v63, v67
    v_min3_u32 v13, v13, v71, v75
    v_max3_u32 v12, v12, v71, v75
    v_min3_u32 v13, v13, v79, v47
    v_max3_u32 v12, v12, v79, v47
    v_cmp_ne_u32 vcc, v13, v12
    s_cbranch_vccnz L_retry1
L_got1:
    s_waitcnt vmcnt(0)
    v_add_f32 v48, v48, v52
    v_add_f32 v49, v49, v53
    v_add_f32 v48, v48, v56
    v_add_f32 v49, v49, v57
    v_add_f32 v48, v48, v60
    v_add_f32 v49, v49, v61
    v_add_f32 v48, v48, v64
    v_add_f32 v49, v49, v65
    v_add_f32 v48, v48, v68
    v_add_f32 v49, v49, v69
    v_add_f32 v48, v48, v72
    v_add_f32 v49, v49, v73
    v_add_f32 v48, v48, v76
    v_add_f32 v49, v49, v77
    v_cvt_pk_bf16_f32 v48, v48, v49
    s_branch L_H0b
L_H1b:
    s_barrier
    s_cmp_lt_u32 s5, 5
    s_cselect_b32 s36, 32, s4
    s_cmp_ge_u32 s36, 27
    s_cbranch_scc1 L_H1end
    s_barrier
L_pollg:
    global_load_dwordx4 v[48:51], v7, s[30:31] offset:-4096 sc1
    global_load_dwordx4 v[52:55], v7, s[30:31] offset:-3072 sc1
    global_load_dwordx4 v[56:59], v7, s[30:31] offset:-2048 sc1
    global_load_dwordx4 v[60:63], v7, s[30:31] offset:-1024 sc1
    global_load_dwordx4 v[64:67], v7, s[30:31] offset:0 sc1
    global_load_dwordx4 v[68:71], v7, s[30:31] offset:1024 sc1
    global_load_dwordx4 v[72:75], v7, s[30:31] offset:2048 sc1
    global_load_dwordx4 v[76:79], v7, s[30:31] offset:3072 sc1
L_chkg:
    s_sub_u32 s39, s39, 1
    s_cbranch_scc1 L_gotg
    s_waitcnt vmcnt(0)
    v_min3_u32 v13, v51, v55, v59
    v_max3_u32 v12, v51, v55, v59
    v_min3_u32 v13, v13, v63, v67
    v_max3_u32 v12, v12, v63, v67
    v_min3_u32 v13, v13, v71, v75
    v_max3_u32 v12, v12, v71, v75
    v_min3_u32 v13, v13, v79, v47
    v_max3_u32 v12, v12, v79, v47
    v_cmp_ne_u32 vcc, v13, v12
    s_cbranch_vccnz L_retryg
L_gotg:
    s_waitcnt vmcnt(0)
    v_add_f32 v48, v48, v52
    v_add_f32 v49, v49, v53
    v_add_f32 v48, v48, v56
    v_add_f32 v49, v49, v57
    v_add_f32 v48, v48, v60
    v_add_f32 v49, v49, v61
    v_add_f32 v48, v48, v64
    v_add_f32 v49, v49, v65
    v_add_f32 v48, v48, v68
    v_add_f32 v49, v49, v69
    v_add_f32 v48, v48, v72
    v_add_f32 v49, v49, v73
    v_add_f32 v48, v48, v76
    v_add_f32 v49, v49, v77
    v_cvt_pk_bf16_f32 v48, v48, v49
    v_mov_b32 v49, v48
    s_nop 1
    v_permlane32_swap_b32 v48, v49
    v_lshlrev_b32 v50, 16, v48
    v_and_b32 v51, 0xffff0000, v48
    v_lshlrev_b32 v54, 16, v49
    v_and_b32 v55, 0xffff0000, v49
    v_mul_f32 v52, 0xbfb8aa3b, v50
    v_mul_f32 v53, 0xbfb8aa3b, v51
    v_exp_f32 v52, v52
    v_exp_f32 v53, v53
    v_add_f32 v52, 1.0, v52
    v_add_f32 v53, 1.0, v53
    v_rcp_f32 v52, v52
    v_rcp_f32 v53, v53
    v_cvt_pk_bf16_f32 v52, v52, v52
    v_and_b32 v52, 0xffff0000, v52
    v_cvt_pk_bf16_f32 v53, v53, v53
    v_and_b32 v53, 0xffff0000, v53
    v_mul_f32 v52, v52, v54
    v_mul_f32 v53, v53, v55
    v_cvt_pk_bf16_f32 v52, v52, v52
    v_cvt_pk_bf16_f32 v53, v53, v53
    v_and_b32 v14, 0xff, v14
    ds_write_b64 v14, v[52:53] offset:832
    s_waitcnt lgkmcnt(0)
    s_cmp_lt_u32 s50, 40
    s_cbranch_scc1 L_RED2
    s_endpgm
L_H1end:
    s_cmp_lt_u32 s50, 40
    s_cbranch_scc1 L_RED
    s_endpgm
L_H0b:
    v_lshlrev_b32 v12, 2, v1
    v_mov_b32 v13, 0
    ds_write_b32 v12, v48 offset:576
    v_min3_u32 v16, v50, v54, v58
    v_max3_u32 v17, v50, v54, v58
    v_min3_u32 v16, v16, v62, v66
    v_max3_u32 v17, v17, v62, v66
    v_min3_u32 v16, v16, v70, v74
    v_max3_u32 v17, v17, v70, v74
    v_min3_u32 v16, v16, v78, v46
    v_max3_u32 v17, v17, v78, v46
    v_cmp_ne_u32 s[58:59], v16, v17
    s_waitcnt lgkmcnt(0)
    s_nop 2
    s_cmp_eq_u64 s[58:59], 0
    s_cbranch_scc0 L_thru
L_thrudone:
    s_barrier
    s_barrier
    ds_read_b128 v[16:19], v13 offset:512
    ds_read_b128 v[20:23], v13 offset:528
    ds_read_b128 v[24:27], v13 offset:544
    ds_read_b128 v[28:31], v13 offset:560
    s_waitcnt lgkmcnt(0)
    v_max3_f32 v12, v16, v18, v20
    v_max3_f32 v12, v12, v22, v24
    v_max3_f32 v12, v12, v26, v28
    v_max_f32 v12, v12, v30
    v_sub_f32 v16, v16, v12
    v_sub_f32 v18, v18, v12
    v_sub_f32 v20, v20, v12
    v_sub_f32 v22, v22, v12
    v_sub_f32 v24, v24, v12
    v_sub_f32 v26, v26, v12
    v_sub_f32 v28, v28, v12
    v_sub_f32 v30, v30, v12
    v_mul_f32 v16, 0x3fb8aa3b, v16
    v_mul_f32 v18, 0x3fb8aa3b, v18
    v_mul_f32 v20, 0x3fb8aa3b, v20
    v_mul_f32 v22, 0x3fb8aa3b, v22
    v_mul_f32 v24, 0x3fb8aa3b, v24
    v_mul_f32 v26, 0x3fb8aa3b, v26
    v_mul_f32 v28, 0x3fb8aa3b, v28
    v_mul_f32 v30, 0x3fb8aa3b, v30
    v_exp_f32 v16, v16
    v_exp_f32 v18, v18
    v_exp_f32 v20, v20
    v_exp_f32 v22, v22
    v_exp_f32 v24, v24
    v_exp_f32 v26, v26
    v_exp_f32 v28, v28
    v_exp_f32 v30, v30
    v_mul_f32 v15, v16, v17
    v_fmac_f32 v15, v18, v19
    v_fmac_f32 v15, v20, v21
    v_fmac_f32 v15, v22, v23
    v_fmac_f32 v15, v24, v25
    v_fmac_f32 v15, v26, v27
    v_fmac_f32 v15, v28, v29
    v_fmac_f32 v15, v30, v31
    v_log_f32 v46, v15
    v_rcp_f32 v15, v15
    v_fmac_f32 v46, 0x3fb8aa3b, v12
    v_mul_f32 v16, v16, v15
    v_mul_f32 v18, v18, v15
    v_mul_f32 v20, v20, v15
    v_mul_f32 v22, v22, v15
    v_mul_f32 v24, v24, v15
    v_mul_f32 v26, v26, v15
    v_mul_f32 v28, v28, v15
    v_mul_f32 v30, v30, v15
    s_barrier
    ds_read_b64 v[48:49], v14 offset:5184
    ds_read_b64 v[50:51], v14 offset:5696
    ds_read_b64 v[52:53], v14 offset:6208
    ds_read_b64 v[54:55], v14 offset:6720
    ds_read_b64 v[56:57], v14 offset:7232
    ds_read_b64 v[58:59], v14 offset:7744
    ds_read_b64 v[60:61], v14 offset:8256
    ds_read_b64 v[62:63], v14 offset:8768
    s_waitcnt lgkmcnt(7)
    v_pk_mul_f32 v[44:45], v[16:17], v[48:49] op_sel_hi:[0,1]
    s_waitcnt lgkmcnt(6)
    v_pk_fma_f32 v[44:45], v[18:19], v[50:51], v[44:45] op_sel_hi:[0,1,1]
    s_waitcnt lgkmcnt(5)
    v_pk_fma_f32 v[44:45], v[20:21], v[52:53], v[44:45] op_sel_hi:[0,1,1]
    s_waitcnt lgkmcnt(4)
    v_pk_fma_f32 v[44:45], v[22:23], v[54:55], v[44:45] op_sel_hi:[0,1,1]
    s_waitcnt lgkmcnt(3)
    v_pk_fma_f32 v[44:45], v[24:25], v[56:57], v[44:45] op_sel_hi:[0,1,1]
    s_waitcnt lgkmcnt(2)
    v_pk_fma_f32 v[44:45], v[26:27], v[58:59], v[44:45] op_sel_hi:[0,1,1]
    s_waitcnt lgkmcnt(1)
    v_pk_fma_f32 v[44:45], v[28:29], v[60:61], v[44:45] op_sel_hi:[0,1,1]
    s_waitcnt lgkmcnt(0)
    v_pk_fma_f32 v[44:45], v[30:31], v[62:63], v[44:45] op_sel_hi:[0,1,1]
    s_cmp_eq_u64 s[58:59], 0
    s_cbranch_scc0 L_slow2
    global_store_dwordx4 v8, v[44:47], s[30:31]
L_done2:
    s_barrier
    s_barrier
    ds_read_b64 v[48:49], v14 offset:9280
    ds_read_b64 v[50:51], v14 offset:9792
    ds_read_b64 v[52:53], v14 offset:10304
    ds_read_b64 v[54:55], v14 offset:10816
    ds_read_b64 v[56:57], v14 offset:11328
    ds_read_b64 v[58:59], v14 offset:11840
    ds_read_b64 v[60:61], v14 offset:12352
    ds_read_b64 v[62:63], v14 offset:12864
    s_cmp_lt_u32 s5, 5
    s_waitcnt lgkmcnt(6)
    v_pk_add_f32 v[48:49], v[48:49], v[50:51]
    s_waitcnt lgkmcnt(5)
    v_pk_add_f32 v[48:49], v[48:49], v[52:53]
    s_waitcnt lgkmcnt(4)
    v_pk_add_f32 v[48:49], v[48:49], v[54:55]
    s_waitcnt lgkmcnt(2)
    v_pk_add_f32 v[56:57], v[56:57], v[58:59]
    s_waitcnt lgkmcnt(1)
    v_pk_add_f32 v[56:57], v[56:57], v[60:61]
    s_waitcnt lgkmcnt(0)
    v_pk_add_f32 v[56:57], v[56:57], v[62:63]
    s_cbranch_scc0 L_pubB
    v_pk_add_f32 v[44:45], v[48:49], v[56:57]
    global_store_dwordx4 v9, v[44:47], s[30:31] sc1
    s_endpgm
L_pubB:
    s_cmp_ge_u32 s4, 27
    s_cbranch_scc1 L_pubBend
    v_mov_b32 v51, v47
    v_mov_b32 v59, v47
    global_store_dwordx4 v9, v[48:51], s[30:31] sc1
    s_cmp_eq_u32 s5, 7
    s_cbranch_scc1 L_pubBend
    global_store_dwordx4 v10, v[56:59], s[30:31] sc1
L_pubBend:
    s_endpgm
L_RED:
    s_barrier
L_RED2:
    s_barrier
    s_barrier
    s_barrier
    s_lshl_b32 s36, s50, 12
    s_add_u32 s36, s36, 851968
    v_add_u32 v4, s36, v5
    v_add_u32 v6, 163840, v4
    s_mov_b32 s52, 0xffffff
    s_mov_b32 s53, 0
    v_and_b32 v12, 16, v1
    v_sub_u32 v12, 16, v12
    s_waitcnt vmcnt(0)
    v_lshlrev_b32 v40, v12, v40
    v_and_b32 v40, 0xffff0000, v40
    v_bfe_u32 v12, v1, 4, 1
    v_lshl_add_u32 v11, v12, 1, v11
    s_barrier
    s_mov_b32 s39, 262144
L_poll3b:
    global_load_dwordx4 v[64:67], v6, s[30:31] offset:0 sc1
    global_load_dwordx4 v[68:71], v6, s[30:31] offset:1024 sc1
    global_load_dwordx4 v[72:75], v6, s[30:31] offset:2048 sc1
    global_load_dwordx4 v[76:79], v6, s[30:31] offset:3072 sc1
    global_load_dwordx4 v[48:51], v4, s[30:31] offset:0 sc1
    global_load_dwordx4 v[52:55], v4, s[30:31] offset:1024 sc1
    global_load_dwordx4 v[56:59], v4, s[30:31] offset:2048 sc1
    global_load_dwordx4 v[60:63], v4, s[30:31] offset:3072 sc1
    s_sub_u32 s39, s39, 1
    s_cbranch_scc1 L_got3b
    s_waitcnt vmcnt(4)
    v_cndmask_b32 v79, v47, v79, s[52:53]
    v_min3_u32 v12, v67, v71, v47
    v_max3_u32 v13, v67, v71, v47
    v_min3_u32 v12, v12, v75, v79
    v_max3_u32 v13, v13, v75, v79
    v_cmp_ne_u32 vcc, v12, v13
    s_waitcnt vmcnt(0)
    s_cbranch_vccnz L_poll3b
L_got3b:
    s_waitcnt vmcnt(0)
    v_min3_u32 v12, v51, v55, v47
    v_max3_u32 v13, v51, v55, v47
    v_min3_u32 v12, v12, v59, v63
    v_max3_u32 v13, v13, v59, v63
    v_cmp_ne_u32 vcc, v12, v13
    s_cbranch_vccz L_sumb
    global_load_dwordx4 v[48:51], v4, s[30:31] offset:0 sc1
    global_load_dwordx4 v[52:55], v4, s[30:31] offset:1024 sc1
    global_load_dwordx4 v[56:59], v4, s[30:31] offset:2048 sc1
    global_load_dwordx4 v[60:63], v4, s[30:31] offset:3072 sc1
L_sumb:
    v_cndmask_b32 v76, 0, v76, s[52:53]
    v_cndmask_b32 v77, 0, v77, s[52:53]
    v_pk_add_f32 v[64:65], v[64:65], v[68:69]
    v_pk_add_f32 v[72:73], v[72:73], v[76:77]
    v_pk_add_f32 v[64:65], v[64:65], v[72:73]
    s_nop 1
    v_permlane16_swap_b32 v64, v65
    v_add_f32 v64, v64, v65
    v_mov_b32 v65, v64
    s_nop 1
    v_permlane32_swap_b32 v64, v65
    v_add_f32 v64, v64, v65
    s_nop 1
    v_add_f32_dpp v64, v64, v64 row_ror:8 row_mask:0xf bank_mask:0xf
    v_cvt_pk_bf16_f32 v64, v64, v64
    v_and_b32 v64, 0xffff0000, v64
    s_mov_b32 s39, 262144
    s_branch L_chk3
L_poll3:
    global_load_dwordx4 v[48:51], v4, s[30:31] offset:0 sc1
    global_load_dwordx4 v[52:55], v4, s[30:31] offset:1024 sc1
    global_load_dwordx4 v[56:59], v4, s[30:31] offset:2048 sc1
    global_load_dwordx4 v[60:63], v4, s[30:31] offset:3072 sc1
L_chk3:
    s_sub_u32 s39, s39, 1
    s_cbranch_scc1 L_out3
    s_waitcnt vmcnt(0)
    v_min3_u32 v12, v51, v55, v47
    v_max3_u32 v13, v51, v55, v47
    v_min3_u32 v12, v12, v59, v63
    v_max3_u32 v13, v13, v59, v63
    v_cmp_ne_u32 vcc, v12, v13
    s_cbranch_vccnz L_poll3
L_got3:
    v_pk_add_f32 v[48:49], v[48:49], v[52:53]
    v_pk_add_f32 v[56:57], v[56:57], v[60:61]
    v_pk_add_f32 v[48:49], v[48:49], v[56:57]
    s_nop 1
    v_permlane16_swap_b32 v48, v49
    v_add_f32 v48, v48, v49
    v_mov_b32 v49, v48
    s_nop 1
    v_permlane32_swap_b32 v48, v49
    v_add_f32 v48, v48, v49
    s_nop 1
    v_add_f32_dpp v48, v48, v48 row_ror:8 row_mask:0xf bank_mask:0xf
    v_cvt_pk_bf16_f32 v48, v48, v48
    v_and_b32 v48, 0xffff0000, v48
    v_add_f32 v41, v48, v40
    v_cvt_pk_bf16_f32 v41, v41, v41
    v_and_b32 v41, 0xffff0000, v41
    v_add_f32 v41, v41, v64
    v_cvt_pk_bf16_f32 v41, v41, v41
    s_mov_b64 exec, 16711935
    global_store_short v11, v41, s[26:27]
    s_cmp_eq_u32 s50, 0
    s_cbranch_scc0 L_Rend
    s_mov_b64 exec, 1
    v_mov_b32 v12, 0
    global_store_dword v12, v47, s[30:31]
L_Rend:
L_exit:
    s_endpgm
L_retry1:
    s_sub_u32 s57, s57, 1
    s_cmp_eq_u32 s57, 0
    s_cbranch_scc0 L_poll1
    global_store_dwordx4 v6, v[44:47], s[30:31] sc1
    s_cmp_ge_u32 s4, 27
    s_cbranch_scc1 L_poll1
    global_store_dwordx4 v15, v[32:35], s[30:31] sc1
    s_branch L_poll1
L_retryg:
    global_load_dwordx4 v[48:51], v7, s[30:31] offset:-4096 sc1
    global_load_dwordx4 v[52:55], v7, s[30:31] offset:-3072 sc1
    global_load_dwordx4 v[56:59], v7, s[30:31] offset:-2048 sc1
    global_load_dwordx4 v[60:63], v7, s[30:31] offset:-1024 sc1
    global_load_dwordx4 v[64:67], v7, s[30:31] offset:0 sc1
    global_load_dwordx4 v[68:71], v7, s[30:31] offset:1024 sc1
    global_load_dwordx4 v[72:75], v7, s[30:31] offset:2048 sc1
    global_load_dwordx4 v[76:79], v7, s[30:31] offset:3072 sc1
    s_branch L_chkg
L_thru:
    global_store_dwordx4 v6, v[44:47], s[30:31] sc1
    s_cmp_ge_u32 s4, 27
    s_cbranch_scc1 L_thrudone
    global_store_dwordx4 v15, v[32:35], s[30:31] sc1
    s_branch L_thrudone
L_slow2:
    global_store_dwordx4 v8, v[44:47], s[30:31] sc1
    s_branch L_done2
L_out3:
    s_waitcnt vmcnt(0)
    s_branch L_got3
.section .rodata,"a"
.p2align 6
.amdhsa_kernel parallel_sum__sliding_block_cached__glu_gated_glu__decode_kernel
  .amdhsa_next_free_vgpr 152
  .amdhsa_next_free_sgpr 96
  .amdhsa_accum_offset 152
  .amdhsa_group_segment_fixed_size 0
  .amdhsa_kernarg_size 96
  .amdhsa_user_sgpr_count 2
  .amdhsa_user_sgpr_kernarg_segment_ptr 1
  .amdhsa_system_sgpr_workgroup_id_x 1
  .amdhsa_float_denorm_mode_32 3
.end_amdhsa_kernel
```
